```python
import torch

def _softmax(x, axis=-1):
    return torch.softmax(x, dim=axis)
def _gelu(x):
    return torch.nn.functional.gelu(x, approximate="tanh")
def _silu(x):
    return torch.nn.functional.silu(x)
def _sigmoid(x):
    return torch.sigmoid(x)
def _layernorm(x, axis=-1, eps=1e-5):
    m = x.mean(dim=axis, keepdim=True)
    v = x.var(dim=axis, keepdim=True, unbiased=False)
    return (x - m) / torch.sqrt(v + eps)
def _scatter_add(tgt, idx, src, axis=0):
    return tgt.clone().index_add_(axis, idx, src)
def _segment_sum(src, seg, n):
    out = torch.zeros((n,) + src.shape[1:], dtype=src.dtype)
    return out.index_add_(0, seg, src)
def _pad(x, pw):
    flat = tuple(v for pair in reversed(pw) for v in pair)
    return torch.nn.functional.pad(x, flat)

kernel_name = 'standalone__softmax_full_bidir__decode'

def setup_inputs():

    _w = (lambda a: (lambda t: t.to(torch.bfloat16) if t.is_floating_point() else t)(torch.as_tensor(a)))
    B, H, Sq, Skv, Dh = 4, 16, 1, 16384, 256
    return {
        "q": _w((lambda *s: torch.randn(*s, dtype=torch.bfloat16) * 0.8)(B, H, Sq, Dh)),
        "k": _w((lambda *s: torch.randn(*s, dtype=torch.bfloat16) * 0.8)(B, H, Skv, Dh)),
        "v": _w((lambda *s: torch.randn(*s, dtype=torch.bfloat16) * 0.05)(B, H, Skv, Dh)),
    }

def reference(q, k, v):
    scale = q.shape[-1] ** -0.5
    scores = torch.einsum('bhqd,bhkd->bhqk', q, k) * scale
    attn = _softmax(scores, axis=-1)
    return torch.einsum('bhqk,bhkd->bhqd', attn, v)
```

```asm
; @launch grid=(256,1,1) block=(256,1,1) lds=134272
.amdgcn_target "amdgcn-amd-amdhsa--gfx950"
.text
.globl standalone__softmax_full_bidir__decode_kernel
.p2align 8
.type standalone__softmax_full_bidir__decode_kernel,@function
standalone__softmax_full_bidir__decode_kernel:
    s_cmp_ge_u32 s2, 256
    s_cbranch_scc1 L_done
    s_load_dwordx4 s[4:7], s[0:1], 0
    s_load_dwordx2 s[8:9], s[0:1], 16
    v_lshrrev_b32 v52, 6, v0
    v_and_b32 v1, 63, v0
    v_readfirstlane_b32 s3, v52
    s_lshr_b32 s24, s2, 2
    s_lshl_b32 s26, s2, 21
    s_cmp_lg_u32 s3, 0
    s_cbranch_scc1 L_consumer
    s_setprio 3
    v_lshlrev_b32 v2, 4, v1
    v_mov_b32 v52, 0
    v_lshlrev_b32 v55, 2, v1
    v_add_u32 v55, 131072, v55
    v_cmp_gt_u32 vcc, 16, v1
    s_and_saveexec_b64 s[40:41], vcc
    ds_write_b32 v55, v52
    s_mov_b64 exec, s[40:41]
    s_mov_b32 s20, 0
    s_mov_b32 s25, 0
    s_mov_b32 s21, 0
    s_waitcnt lgkmcnt(0)
    s_add_u32 s12, s6, s26
    s_addc_u32 s13, s7, 0
    s_mov_b32 s14, 2097152
    s_mov_b32 s15, 0x20000
    s_add_u32 s16, s8, s26
    s_addc_u32 s17, s9, 0
    s_mov_b32 s18, 2097152
    s_mov_b32 s19, 0x20000
    s_add_u32 m0, s25, 0
    s_nop 0
    buffer_load_dwordx4 v2, s[12:15], s20 offen nt lds
    buffer_load_dwordx4 v2, s[12:15], s20 offen offset:1024 nt lds
    buffer_load_dwordx4 v2, s[12:15], s20 offen offset:2048 nt lds
    buffer_load_dwordx4 v2, s[12:15], s20 offen offset:3072 nt lds
    s_add_u32 m0, s25, 4096
    s_add_u32 s27, s20, 4096
    s_nop 0
    buffer_load_dwordx4 v2, s[12:15], s27 offen nt lds
    buffer_load_dwordx4 v2, s[12:15], s27 offen offset:1024 nt lds
    buffer_load_dwordx4 v2, s[12:15], s27 offen offset:2048 nt lds
    buffer_load_dwordx4 v2, s[12:15], s27 offen offset:3072 nt lds
    s_add_u32 m0, s25, 8192
    s_nop 0
    buffer_load_dwordx4 v2, s[16:19], s20 offen nt lds
    buffer_load_dwordx4 v2, s[16:19], s20 offen offset:1024 nt lds
    buffer_load_dwordx4 v2, s[16:19], s20 offen offset:2048 nt lds
    buffer_load_dwordx4 v2, s[16:19], s20 offen offset:3072 nt lds
    s_add_u32 m0, s25, 12288
    s_add_u32 s27, s20, 4096
    s_nop 0
    buffer_load_dwordx4 v2, s[16:19], s27 offen nt lds
    buffer_load_dwordx4 v2, s[16:19], s27 offen offset:1024 nt lds
    buffer_load_dwordx4 v2, s[16:19], s27 offen offset:2048 nt lds
    buffer_load_dwordx4 v2, s[16:19], s27 offen offset:3072 nt lds
    s_add_u32 s20, s20, 8192
    s_add_u32 s25, s25, 16384
    s_and_b32 s25, s25, 131071
    s_add_u32 s21, s21, 1
    s_barrier
    s_add_u32 m0, s25, 0
    s_nop 0
    buffer_load_dwordx4 v2, s[12:15], s20 offen nt lds
    buffer_load_dwordx4 v2, s[12:15], s20 offen offset:1024 nt lds
    buffer_load_dwordx4 v2, s[12:15], s20 offen offset:2048 nt lds
    buffer_load_dwordx4 v2, s[12:15], s20 offen offset:3072 nt lds
    s_add_u32 m0, s25, 4096
    s_add_u32 s27, s20, 4096
    s_waitcnt vmcnt(19)
    buffer_load_dwordx4 v2, s[12:15], s27 offen nt lds
    s_waitcnt vmcnt(19)
    buffer_load_dwordx4 v2, s[12:15], s27 offen offset:1024 nt lds
    s_waitcnt vmcnt(19)
    buffer_load_dwordx4 v2, s[12:15], s27 offen offset:2048 nt lds
    s_waitcnt vmcnt(19)
    buffer_load_dwordx4 v2, s[12:15], s27 offen offset:3072 nt lds
    s_add_u32 m0, s25, 8192
    s_waitcnt vmcnt(19)
    buffer_load_dwordx4 v2, s[16:19], s20 offen nt lds
    s_waitcnt vmcnt(19)
    buffer_load_dwordx4 v2, s[16:19], s20 offen offset:1024 nt lds
    s_waitcnt vmcnt(19)
    buffer_load_dwordx4 v2, s[16:19], s20 offen offset:2048 nt lds
    s_waitcnt vmcnt(19)
    buffer_load_dwordx4 v2, s[16:19], s20 offen offset:3072 nt lds
    s_add_u32 m0, s25, 12288
    s_add_u32 s27, s20, 4096
    s_waitcnt vmcnt(19)
    buffer_load_dwordx4 v2, s[16:19], s27 offen nt lds
    s_waitcnt vmcnt(19)
    buffer_load_dwordx4 v2, s[16:19], s27 offen offset:1024 nt lds
    s_waitcnt vmcnt(19)
    buffer_load_dwordx4 v2, s[16:19], s27 offen offset:2048 nt lds
    s_waitcnt vmcnt(19)
    buffer_load_dwordx4 v2, s[16:19], s27 offen offset:3072 nt lds
    s_add_u32 s20, s20, 8192
    s_add_u32 s25, s25, 16384
    s_and_b32 s25, s25, 131071
    s_add_u32 s21, s21, 1
    v_mov_b32 v8, 131072
    v_mov_b32 v9, 1
    v_mov_b32 v10, 131116
    s_mov_b32 s47, -5
    v_mov_b32 v54, 0x7fffffff
L_lloop:
L_lfrees:
    s_waitcnt lgkmcnt(0)
    v_cmp_le_i32 vcc, s47, v54
    s_cbranch_vccnz L_lgos
    s_sleep 1
    ds_read_b32 v54, v55
    s_branch L_lfrees
L_lgos:
    s_add_u32 s47, s47, 1
    s_add_u32 m0, s25, 0
    s_waitcnt vmcnt(19)
    buffer_load_dwordx4 v2, s[12:15], s20 offen nt lds
    s_waitcnt vmcnt(19)
    buffer_load_dwordx4 v2, s[12:15], s20 offen offset:1024 nt lds
    s_waitcnt vmcnt(19)
    buffer_load_dwordx4 v2, s[12:15], s20 offen offset:2048 nt lds
    s_waitcnt vmcnt(19)
    buffer_load_dwordx4 v2, s[12:15], s20 offen offset:3072 nt lds
    ds_write_b32 v8, v9
    s_add_u32 m0, s25, 4096
    s_add_u32 s27, s20, 4096
    s_waitcnt vmcnt(19)
    buffer_load_dwordx4 v2, s[12:15], s27 offen nt lds
    v_add_u32 v9, 1, v9
    v_add_u32 v8, 4, v8
    v_and_b32 v8, 31, v8
    v_or_b32 v8, 131072, v8
    s_waitcnt vmcnt(19)
    buffer_load_dwordx4 v2, s[12:15], s27 offen offset:1024 nt lds
    s_waitcnt vmcnt(19)
    buffer_load_dwordx4 v2, s[12:15], s27 offen offset:2048 nt lds
    s_waitcnt vmcnt(19)
    buffer_load_dwordx4 v2, s[12:15], s27 offen offset:3072 nt lds
    s_add_u32 m0, s25, 8192
    s_waitcnt vmcnt(19)
    buffer_load_dwordx4 v2, s[16:19], s20 offen nt lds
    ds_read_b32 v54, v10
    v_mov_b32 v55, v10
    v_add_u32 v10, 4, v10
    v_and_b32 v10, 31, v10
    v_or_b32 v10, 131104, v10
    s_waitcnt vmcnt(19)
    buffer_load_dwordx4 v2, s[16:19], s20 offen offset:1024 nt lds
    s_waitcnt vmcnt(19)
    buffer_load_dwordx4 v2, s[16:19], s20 offen offset:2048 nt lds
    s_waitcnt vmcnt(19)
    buffer_load_dwordx4 v2, s[16:19], s20 offen offset:3072 nt lds
    s_add_u32 m0, s25, 12288
    s_add_u32 s27, s20, 4096
    s_waitcnt vmcnt(19)
    buffer_load_dwordx4 v2, s[16:19], s27 offen nt lds
    s_waitcnt vmcnt(19)
    buffer_load_dwordx4 v2, s[16:19], s27 offen offset:1024 nt lds
    s_waitcnt vmcnt(19)
    buffer_load_dwordx4 v2, s[16:19], s27 offen offset:2048 nt lds
    s_waitcnt vmcnt(19)
    buffer_load_dwordx4 v2, s[16:19], s27 offen offset:3072 nt lds
    s_add_u32 s20, s20, 8192
    s_add_u32 s25, s25, 16384
    s_and_b32 s25, s25, 131071
    s_add_u32 s21, s21, 1
    s_cmp_lt_u32 s21, 232
    s_cbranch_scc1 L_lloop
L_lfreex0:
    s_waitcnt lgkmcnt(0)
    v_cmp_le_i32 vcc, s47, v54
    s_cbranch_vccnz L_lgox0
    s_sleep 1
    ds_read_b32 v54, v55
    s_branch L_lfreex0
L_lgox0:
    s_add_u32 s47, s47, 1
    s_add_u32 m0, s25, 0
    s_waitcnt vmcnt(33)
    buffer_load_dwordx4 v2, s[12:15], s20 offen nt lds
    s_waitcnt vmcnt(33)
    buffer_load_dwordx4 v2, s[12:15], s20 offen offset:1024 nt lds
    s_waitcnt vmcnt(33)
    buffer_load_dwordx4 v2, s[12:15], s20 offen offset:2048 nt lds
    s_waitcnt vmcnt(33)
    buffer_load_dwordx4 v2, s[12:15], s20 offen offset:3072 nt lds
    s_add_u32 m0, s25, 4096
    s_add_u32 s27, s20, 4096
    s_waitcnt vmcnt(33)
    buffer_load_dwordx4 v2, s[12:15], s27 offen nt lds
    s_waitcnt vmcnt(33)
    buffer_load_dwordx4 v2, s[12:15], s27 offen offset:1024 nt lds
    s_waitcnt vmcnt(33)
    buffer_load_dwordx4 v2, s[12:15], s27 offen offset:2048 nt lds
    s_waitcnt vmcnt(33)
    buffer_load_dwordx4 v2, s[12:15], s27 offen offset:3072 nt lds
    s_add_u32 m0, s25, 8192
    s_waitcnt vmcnt(33)
    buffer_load_dwordx4 v2, s[16:19], s20 offen nt lds
    ds_read_b32 v54, v10
    v_mov_b32 v55, v10
    v_add_u32 v10, 4, v10
    v_and_b32 v10, 31, v10
    v_or_b32 v10, 131104, v10
    s_waitcnt vmcnt(33)
    buffer_load_dwordx4 v2, s[16:19], s20 offen offset:1024 nt lds
    s_waitcnt vmcnt(33)
    buffer_load_dwordx4 v2, s[16:19], s20 offen offset:2048 nt lds
    s_waitcnt vmcnt(33)
    buffer_load_dwordx4 v2, s[16:19], s20 offen offset:3072 nt lds
    s_add_u32 m0, s25, 12288
    s_add_u32 s27, s20, 4096
    s_waitcnt vmcnt(33)
    buffer_load_dwordx4 v2, s[16:19], s27 offen nt lds
    s_waitcnt vmcnt(33)
    buffer_load_dwordx4 v2, s[16:19], s27 offen offset:1024 nt lds
    s_waitcnt vmcnt(33)
    buffer_load_dwordx4 v2, s[16:19], s27 offen offset:2048 nt lds
    s_waitcnt vmcnt(33)
    buffer_load_dwordx4 v2, s[16:19], s27 offen offset:3072 nt lds
    s_add_u32 s20, s20, 8192
    s_add_u32 s25, s25, 16384
    s_and_b32 s25, s25, 131071
    s_add_u32 s21, s21, 1
L_ploop:
L_lfreep:
    s_waitcnt lgkmcnt(0)
    v_cmp_le_i32 vcc, s47, v54
    s_cbranch_vccnz L_lgop
    s_sleep 1
    ds_read_b32 v54, v55
    s_branch L_lfreep
L_lgop:
    s_add_u32 s47, s47, 1
    s_add_u32 m0, s25, 0
    s_waitcnt vmcnt(33)
    buffer_load_dwordx4 v2, s[12:15], s20 offen nt lds
    s_waitcnt vmcnt(33)
    buffer_load_dwordx4 v2, s[12:15], s20 offen offset:1024 nt lds
    ds_write_b32 v8, v9
    s_waitcnt vmcnt(33)
    buffer_load_dwordx4 v2, s[12:15], s20 offen offset:2048 nt lds
    v_add_u32 v9, 1, v9
    v_add_u32 v8, 4, v8
    v_and_b32 v8, 31, v8
    v_or_b32 v8, 131072, v8
    s_waitcnt vmcnt(33)
    buffer_load_dwordx4 v2, s[12:15], s20 offen offset:3072 nt lds
    s_add_u32 m0, s25, 4096
    s_add_u32 s27, s20, 4096
    s_waitcnt vmcnt(33)
    buffer_load_dwordx4 v2, s[12:15], s27 offen nt lds
    s_waitcnt vmcnt(33)
    buffer_load_dwordx4 v2, s[12:15], s27 offen offset:1024 nt lds
    s_waitcnt vmcnt(33)
    buffer_load_dwordx4 v2, s[12:15], s27 offen offset:2048 nt lds
    s_waitcnt vmcnt(33)
    buffer_load_dwordx4 v2, s[12:15], s27 offen offset:3072 nt lds
    s_add_u32 m0, s25, 8192
    s_waitcnt vmcnt(33)
    buffer_load_dwordx4 v2, s[16:19], s20 offen nt lds
    ds_read_b32 v54, v10
    v_mov_b32 v55, v10
    v_add_u32 v10, 4, v10
    v_and_b32 v10, 31, v10
    v_or_b32 v10, 131104, v10
    s_waitcnt vmcnt(33)
    buffer_load_dwordx4 v2, s[16:19], s20 offen offset:1024 nt lds
    s_waitcnt vmcnt(33)
    buffer_load_dwordx4 v2, s[16:19], s20 offen offset:2048 nt lds
    s_waitcnt vmcnt(33)
    buffer_load_dwordx4 v2, s[16:19], s20 offen offset:3072 nt lds
    s_add_u32 m0, s25, 12288
    s_add_u32 s27, s20, 4096
    s_waitcnt vmcnt(33)
    buffer_load_dwordx4 v2, s[16:19], s27 offen nt lds
    s_waitcnt vmcnt(33)
    buffer_load_dwordx4 v2, s[16:19], s27 offen offset:1024 nt lds
    s_waitcnt vmcnt(33)
    buffer_load_dwordx4 v2, s[16:19], s27 offen offset:2048 nt lds
    s_waitcnt vmcnt(33)
    buffer_load_dwordx4 v2, s[16:19], s27 offen offset:3072 nt lds
    s_add_u32 s20, s20, 8192
    s_add_u32 s25, s25, 16384
    s_and_b32 s25, s25, 131071
    s_add_u32 s21, s21, 1
    s_cmp_lt_u32 s21, 256
    s_cbranch_scc1 L_ploop
    s_waitcnt vmcnt(32)
    ds_write_b32 v8, v9
    v_add_u32 v9, 1, v9
    v_add_u32 v8, 4, v8
    v_and_b32 v8, 31, v8
    v_or_b32 v8, 131072, v8
    s_waitcnt vmcnt(16)
    ds_write_b32 v8, v9
    v_add_u32 v9, 1, v9
    v_add_u32 v8, 4, v8
    v_and_b32 v8, 31, v8
    v_or_b32 v8, 131072, v8
    s_waitcnt vmcnt(0)
    ds_write_b32 v8, v9
    v_add_u32 v9, 1, v9
    v_add_u32 v8, 4, v8
    v_and_b32 v8, 31, v8
    v_or_b32 v8, 131072, v8
    s_waitcnt lgkmcnt(0)
    s_endpgm
L_consumer:
    s_load_dwordx4 s[52:55], s[0:1], 24
    s_load_dwordx2 s[56:57], s[0:1], 40
    v_lshrrev_b32 v53, 4, v1
    v_and_b32 v52, 15, v1
    v_lshlrev_b32 v2, 9, v53
    v_lshl_add_u32 v2, v52, 4, v2
    v_lshlrev_b32 v22, 4, v52
    s_lshl_b32 s27, s24, 9
    s_mov_b32 s23, 0x3db8aa3b
    s_waitcnt lgkmcnt(0)
    s_add_u32 s4, s4, s27
    s_addc_u32 s5, s5, 0
    global_load_dwordx4 v[4:7], v22, s[4:5]
    global_load_dwordx4 v[8:11], v22, s[4:5] offset:256
    v_and_b32 v53, 1, v52
    v_lshrrev_b32 v52, 1, v52
    v_mov_b32 v22, 0xffff
    v_mov_b32 v15, 0xffff0000
    v_cmp_eq_u32 vcc, 1, v53
    s_nop 1
    v_cndmask_b32 v22, v22, v15, vcc
    v_cmp_eq_u32 vcc, 0, v52
    s_nop 1
    v_cndmask_b32 v24, 0, v22, vcc
    v_cmp_eq_u32 vcc, 1, v52
    s_nop 1
    v_cndmask_b32 v25, 0, v22, vcc
    v_cmp_eq_u32 vcc, 2, v52
    s_nop 1
    v_cndmask_b32 v26, 0, v22, vcc
    v_cmp_eq_u32 vcc, 3, v52
    s_nop 1
    v_cndmask_b32 v27, 0, v22, vcc
    v_mov_b32 v12, 0xff800000
    v_mov_b32 v13, 0xff800000
    v_mov_b32 v14, 0
    v_mov_b32 v28, 0
    v_mov_b32 v29, 0
    v_mov_b32 v30, 0
    v_mov_b32 v31, 0
    v_mov_b32 v32, 0
    v_mov_b32 v33, 0
    v_mov_b32 v34, 0
    v_mov_b32 v35, 0
    s_sub_u32 s21, s3, 1
    s_barrier
    s_waitcnt vmcnt(0)
L_cloop:
    s_and_b32 s25, s21, 7
    s_lshl_b32 s28, s25, 2
    s_add_u32 s28, s28, 131072
    v_mov_b32 v55, s28
    s_add_u32 s22, s21, 1
    s_lshl_b32 s29, s25, 14
    v_add_u32 v3, s29, v2
L_cpoll:
    ds_read_b32 v54, v55
    s_waitcnt lgkmcnt(0)
    v_cmp_eq_u32 vcc, s22, v54
    s_cbranch_vccnz L_cgo
    s_sleep 1
    s_branch L_cpoll
L_cgo:
    ds_read_b128 v[56:59], v3 offset:0
    ds_read_b128 v[60:63], v3 offset:256
    ds_read_b128 v[64:67], v3 offset:2048
    ds_read_b128 v[68:71], v3 offset:2304
    ds_read_b128 v[72:75], v3 offset:4096
    ds_read_b128 v[76:79], v3 offset:4352
    ds_read_b128 v[80:83], v3 offset:6144
    ds_read_b128 v[84:87], v3 offset:6400
    ds_read_b128 v[88:91], v3 offset:8192
    ds_read_b128 v[92:95], v3 offset:8448
    ds_read_b128 v[96:99], v3 offset:10240
    ds_read_b128 v[100:103], v3 offset:10496
    ds_read_b128 v[104:107], v3 offset:12288
    ds_read_b128 v[108:111], v3 offset:12544
    ds_read_b128 v[112:115], v3 offset:14336
    ds_read_b128 v[116:119], v3 offset:14592
    s_waitcnt lgkmcnt(8)
    v_dot2_f32_bf16 v16, v56, v4, 0
    v_dot2_f32_bf16 v17, v64, v4, 0
    v_dot2_f32_bf16 v18, v72, v4, 0
    v_dot2_f32_bf16 v19, v80, v4, 0
    v_dot2_f32_bf16 v16, v57, v5, v16
    v_dot2_f32_bf16 v17, v65, v5, v17
    v_dot2_f32_bf16 v18, v73, v5, v18
    v_dot2_f32_bf16 v19, v81, v5, v19
    v_dot2_f32_bf16 v16, v58, v6, v16
    v_dot2_f32_bf16 v17, v66, v6, v17
    v_dot2_f32_bf16 v18, v74, v6, v18
    v_dot2_f32_bf16 v19, v82, v6, v19
    v_dot2_f32_bf16 v16, v59, v7, v16
    v_dot2_f32_bf16 v17, v67, v7, v17
    v_dot2_f32_bf16 v18, v75, v7, v18
    v_dot2_f32_bf16 v19, v83, v7, v19
    v_dot2_f32_bf16 v16, v60, v8, v16
    v_dot2_f32_bf16 v17, v68, v8, v17
    v_dot2_f32_bf16 v18, v76, v8, v18
    v_dot2_f32_bf16 v19, v84, v8, v19
    v_dot2_f32_bf16 v16, v61, v9, v16
    v_dot2_f32_bf16 v17, v69, v9, v17
    v_dot2_f32_bf16 v18, v77, v9, v18
    v_dot2_f32_bf16 v19, v85, v9, v19
    v_dot2_f32_bf16 v16, v62, v10, v16
    v_dot2_f32_bf16 v17, v70, v10, v17
    v_dot2_f32_bf16 v18, v78, v10, v18
    v_dot2_f32_bf16 v19, v86, v10, v19
    v_dot2_f32_bf16 v16, v63, v11, v16
    v_dot2_f32_bf16 v17, v71, v11, v17
    v_dot2_f32_bf16 v18, v79, v11, v18
    v_dot2_f32_bf16 v19, v87, v11, v19
    s_waitcnt lgkmcnt(0)
    v_mov_b32 v52, s22
    ds_write_b32 v55, v52 offset:32
    s_nop 0
    v_add_f32_dpp v20, v16, v16 row_ror:8 row_mask:0xf bank_mask:0x3
    v_add_f32_dpp v21, v18, v18 row_ror:8 row_mask:0xf bank_mask:0x3
    v_add_f32_dpp v20, v17, v17 row_ror:8 row_mask:0xf bank_mask:0xc
    v_add_f32_dpp v21, v19, v19 row_ror:8 row_mask:0xf bank_mask:0xc
    s_nop 0
    v_add_f32_dpp v15, v20, v20 row_shl:4 row_mask:0xf bank_mask:0x5
    v_add_f32_dpp v15, v21, v21 row_shr:4 row_mask:0xf bank_mask:0xa
    s_nop 1
    v_add_f32_dpp v15, v15, v15 quad_perm:[2,3,0,1] row_mask:0xf bank_mask:0xf
    s_nop 1
    v_add_f32_dpp v15, v15, v15 quad_perm:[1,0,3,2] row_mask:0xf bank_mask:0xf
    v_cmp_gt_f32 vcc, v15, v12
    s_cbranch_vccnz L_rare
L_back:
    v_fma_f32 v22, v15, s23, -v13
    v_exp_f32 v22, v22
    s_nop 0
    v_cvt_pk_bf16_f32 v23, v22, v22
    v_add_f32 v14, v14, v22
    s_nop 0
    v_and_b32_dpp v36, v23, v24 row_newbcast:0 row_mask:0xf bank_mask:0xf
    v_and_b32_dpp v37, v23, v25 row_newbcast:0 row_mask:0xf bank_mask:0xf
    v_and_b32_dpp v38, v23, v26 row_newbcast:0 row_mask:0xf bank_mask:0xf
    v_and_b32_dpp v39, v23, v27 row_newbcast:0 row_mask:0xf bank_mask:0xf
    v_and_b32_dpp v40, v23, v24 row_newbcast:8 row_mask:0xf bank_mask:0xf
    v_and_b32_dpp v41, v23, v25 row_newbcast:8 row_mask:0xf bank_mask:0xf
    v_and_b32_dpp v42, v23, v26 row_newbcast:8 row_mask:0xf bank_mask:0xf
    v_and_b32_dpp v43, v23, v27 row_newbcast:8 row_mask:0xf bank_mask:0xf
    v_and_b32_dpp v44, v23, v24 row_newbcast:4 row_mask:0xf bank_mask:0xf
    v_and_b32_dpp v45, v23, v25 row_newbcast:4 row_mask:0xf bank_mask:0xf
    v_and_b32_dpp v46, v23, v26 row_newbcast:4 row_mask:0xf bank_mask:0xf
    v_and_b32_dpp v47, v23, v27 row_newbcast:4 row_mask:0xf bank_mask:0xf
    v_and_b32_dpp v48, v23, v24 row_newbcast:12 row_mask:0xf bank_mask:0xf
    v_and_b32_dpp v49, v23, v25 row_newbcast:12 row_mask:0xf bank_mask:0xf
    v_and_b32_dpp v50, v23, v26 row_newbcast:12 row_mask:0xf bank_mask:0xf
    v_and_b32_dpp v51, v23, v27 row_newbcast:12 row_mask:0xf bank_mask:0xf
    s_nop 1
    v_mfma_f32_16x16x32_bf16 v[28:31], v[36:39], v[88:91], v[28:31]
    v_mfma_f32_16x16x32_bf16 v[32:35], v[36:39], v[92:95], v[32:35]
    v_mfma_f32_16x16x32_bf16 v[28:31], v[40:43], v[96:99], v[28:31]
    v_mfma_f32_16x16x32_bf16 v[32:35], v[40:43], v[100:103], v[32:35]
    v_mfma_f32_16x16x32_bf16 v[28:31], v[44:47], v[104:107], v[28:31]
    v_mfma_f32_16x16x32_bf16 v[32:35], v[44:47], v[108:111], v[32:35]
    v_mfma_f32_16x16x32_bf16 v[28:31], v[48:51], v[112:115], v[28:31]
    v_mfma_f32_16x16x32_bf16 v[32:35], v[48:51], v[116:119], v[32:35]
    s_add_u32 s21, s21, 3
    s_cmp_lt_u32 s21, 256
    s_cbranch_scc1 L_cloop
    s_mov_b64 s[4:5], s[52:53]
    s_mov_b64 s[6:7], s[54:55]
    s_mov_b64 s[8:9], s[56:57]
    s_sub_u32 s3, s3, 1
    v_add_f32_dpp v52, v14, v14 row_ror:4 row_mask:0xf bank_mask:0xf
    s_nop 1
    v_add_f32_dpp v52, v52, v52 row_ror:8 row_mask:0xf bank_mask:0xf
    v_and_b32 v53, 15, v1
    v_lshrrev_b32 v22, 4, v1
    v_lshlrev_b32 v53, 5, v53
    v_lshl_add_u32 v53, v22, 4, v53
    s_lshl_b32 s26, s3, 10
    s_add_u32 s26, s26, 131136
    v_add_u32 v53, s26, v53
    s_lshl_b32 s26, s3, 4
    s_add_u32 s26, s26, 134208
    v_lshl_add_u32 v22, v22, 2, s26
    s_lshl_b32 s26, s3, 2
    s_add_u32 s26, s26, 134256
    v_mov_b32 v15, s26
    ds_write_b32 v22, v52
    ds_write_b32 v15, v13
    s_nop 4
    s_mov_b32 exec_hi, 0
    ds_write_b128 v53, v[28:31]
    ds_write_b128 v53, v[32:35] offset:512
    s_mov_b32 exec_hi, -1
    s_waitcnt lgkmcnt(0)
    s_barrier
    s_cmp_lg_u32 s3, 0
    s_cbranch_scc1 L_done_stamp
    v_lshlrev_b32 v53, 4, v1
    v_add_u32 v52, 131136, v53
    v_mov_b32 v22, 134208
    ds_read_b128 v[56:59], v52 offset:0
    ds_read_b128 v[60:63], v52 offset:1024
    ds_read_b128 v[64:67], v52 offset:2048
    ds_read_b128 v[68:71], v22 offset:0
    ds_read_b128 v[72:75], v22 offset:16
    ds_read_b128 v[76:79], v22 offset:32
    ds_read_b128 v[80:83], v22 offset:48
    s_waitcnt lgkmcnt(0)
    v_max_f32 v12, v80, v81
    v_max_f32 v12, v12, v82
    v_sub_f32 v80, v80, v12
    v_sub_f32 v81, v81, v12
    v_sub_f32 v82, v82, v12
    v_exp_f32 v80, v80
    v_exp_f32 v81, v81
    v_exp_f32 v82, v82
    v_add_f32 v68, v68, v69
    v_add_f32 v70, v70, v71
    v_add_f32 v72, v72, v73
    v_add_f32 v74, v74, v75
    v_add_f32 v76, v76, v77
    v_add_f32 v78, v78, v79
    v_add_f32 v68, v68, v70
    v_add_f32 v72, v72, v74
    v_add_f32 v76, v76, v78
    v_mul_f32 v14, v68, v80
    v_fma_f32 v14, v72, v81, v14
    v_fma_f32 v14, v76, v82, v14
    v_mul_f32 v28, v56, v80
    v_mul_f32 v29, v57, v80
    v_mul_f32 v30, v58, v80
    v_mul_f32 v31, v59, v80
    v_fma_f32 v28, v60, v81, v28
    v_fma_f32 v29, v61, v81, v29
    v_fma_f32 v30, v62, v81, v30
    v_fma_f32 v31, v63, v81, v31
    v_fma_f32 v28, v64, v82, v28
    v_fma_f32 v29, v65, v82, v29
    v_fma_f32 v30, v66, v82, v30
    v_fma_f32 v31, v67, v82, v31
    s_lshl_b32 s26, s2, 11
    s_add_u32 s10, s8, s26
    s_addc_u32 s11, s9, 0
    v_mov_b32 v32, v12
    v_mov_b32 v33, v14
    global_store_dwordx4 v53, v[28:31], s[10:11] sc1
    v_mov_b32 v22, 0
    s_mov_b64 exec, 1
    global_store_dwordx2 v22, v[32:33], s[10:11] offset:1024 sc1
    s_waitcnt vmcnt(0)
    s_lshl_b32 s26, s24, 2
    v_mov_b32 v52, s26
    v_mov_b32 v15, 1
    global_atomic_add v20, v52, v15, s[6:7] sc0
    s_waitcnt vmcnt(0)
    v_readfirstlane_b32 s26, v20
    s_mov_b64 exec, -1
    s_cmp_lg_u32 s26, 3
    s_cbranch_scc1 L_done_stamp
    s_lshl_b32 s26, s24, 13
    s_add_u32 s10, s8, s26
    s_addc_u32 s11, s9, 0
    v_add_u32 v52, 0, v53
    global_load_dwordx4 v[56:59], v52, s[10:11] sc1
    v_mov_b32 v52, 1024
    global_load_dwordx2 v[72:73], v52, s[10:11] sc1
    v_add_u32 v52, 2048, v53
    global_load_dwordx4 v[60:63], v52, s[10:11] sc1
    v_mov_b32 v52, 3072
    global_load_dwordx2 v[74:75], v52, s[10:11] sc1
    v_add_u32 v52, 4096, v53
    global_load_dwordx4 v[64:67], v52, s[10:11] sc1
    v_mov_b32 v52, 5120
    global_load_dwordx2 v[76:77], v52, s[10:11] sc1
    v_add_u32 v52, 6144, v53
    global_load_dwordx4 v[68:71], v52, s[10:11] sc1
    v_mov_b32 v52, 7168
    global_load_dwordx2 v[78:79], v52, s[10:11] sc1
    s_waitcnt vmcnt(0)
    v_max_f32 v12, v72, v74
    v_max_f32 v12, v12, v76
    v_max_f32 v12, v12, v78
    v_sub_f32 v72, v72, v12
    v_sub_f32 v74, v74, v12
    v_sub_f32 v76, v76, v12
    v_sub_f32 v78, v78, v12
    v_exp_f32 v72, v72
    v_exp_f32 v74, v74
    v_exp_f32 v76, v76
    v_exp_f32 v78, v78
    s_nop 0
    v_mul_f32 v14, v72, v73
    v_fma_f32 v14, v74, v75, v14
    v_fma_f32 v14, v76, v77, v14
    v_fma_f32 v14, v78, v79, v14
    v_mul_f32 v28, v56, v72
    v_mul_f32 v29, v57, v72
    v_mul_f32 v30, v58, v72
    v_mul_f32 v31, v59, v72
    v_fma_f32 v28, v60, v74, v28
    v_fma_f32 v29, v61, v74, v29
    v_fma_f32 v30, v62, v74, v30
    v_fma_f32 v31, v63, v74, v31
    v_fma_f32 v28, v64, v76, v28
    v_fma_f32 v29, v65, v76, v29
    v_fma_f32 v30, v66, v76, v30
    v_fma_f32 v31, v67, v76, v31
    v_fma_f32 v28, v68, v78, v28
    v_fma_f32 v29, v69, v78, v29
    v_fma_f32 v30, v70, v78, v30
    v_fma_f32 v31, v71, v78, v31
    v_rcp_f32 v14, v14
    s_nop 0
    v_mul_f32 v28, v28, v14
    v_mul_f32 v29, v29, v14
    v_mul_f32 v30, v30, v14
    v_mul_f32 v31, v31, v14
    v_cvt_pk_bf16_f32 v32, v28, v29
    v_cvt_pk_bf16_f32 v33, v30, v31
    s_lshl_b32 s26, s24, 9
    s_add_u32 s4, s4, s26
    s_addc_u32 s5, s5, 0
    v_lshlrev_b32 v52, 3, v1
    global_store_dwordx2 v52, v[32:33], s[4:5]
L_done_stamp:
L_done:
    s_endpgm
L_rare:
    v_max_f32_dpp v52, v15, v15 row_ror:4 row_mask:0xf bank_mask:0xf
    s_nop 1
    v_max_f32_dpp v52, v52, v52 row_ror:8 row_mask:0xf bank_mask:0xf
    s_nop 1
    v_readlane_b32 s40, v52, 0
    v_readlane_b32 s41, v52, 16
    v_readlane_b32 s42, v52, 32
    v_readlane_b32 s43, v52, 48
    s_nop 1
    v_max_f32 v52, s40, v12
    v_max_f32 v52, s41, v52
    v_max_f32 v52, s42, v52
    v_max_f32 v52, s43, v52
    v_sub_f32 v53, v12, v52
    v_mul_f32 v53, s23, v53
    v_exp_f32 v53, v53
    v_mov_b32 v12, v52
    v_mul_f32 v13, s23, v52
    v_mul_f32 v14, v14, v53
    v_mul_f32 v28, v28, v53
    v_mul_f32 v29, v29, v53
    v_mul_f32 v30, v30, v53
    v_mul_f32 v31, v31, v53
    v_mul_f32 v32, v32, v53
    v_mul_f32 v33, v33, v53
    v_mul_f32 v34, v34, v53
    v_mul_f32 v35, v35, v53
    s_branch L_back
.section .rodata,"a"
.p2align 6
.amdhsa_kernel standalone__softmax_full_bidir__decode_kernel
  .amdhsa_next_free_vgpr 120
  .amdhsa_next_free_sgpr 64
  .amdhsa_accum_offset 120
  .amdhsa_group_segment_fixed_size 0
  .amdhsa_kernarg_size 48
  .amdhsa_user_sgpr_count 2
  .amdhsa_user_sgpr_kernarg_segment_ptr 1
  .amdhsa_system_sgpr_workgroup_id_x 1
.end_amdhsa_kernel
```
